```python
import torch

def _softmax(x, axis=-1):
    return torch.softmax(x, dim=axis)

def _gelu(x):
    return torch.nn.functional.gelu(x, approximate='tanh')

def _silu(x):
    return torch.nn.functional.silu(x)

def _sigmoid(x):
    return torch.sigmoid(x)

def _layernorm(x, axis=-1, eps=1e-05):
    m = x.mean(dim=axis, keepdim=True)
    v = x.var(dim=axis, keepdim=True, unbiased=False)
    return (x - m) / torch.sqrt(v + eps)

def _scatter_add(tgt, idx, src, axis=0):
    return tgt.clone().index_add_(axis, idx, src)

def _segment_sum(src, seg, n):
    out = torch.zeros((n,) + src.shape[1:], dtype=src.dtype)
    return out.index_add_(0, seg, src)

def _pad(x, pw):
    flat = tuple((v for pair in reversed(pw) for v in pair))
    return torch.nn.functional.pad(x, flat)
kernel_name = 'standalone__tree_speculative_verify_tree_attention_over_candidate_token_tree__decode'

def setup_inputs():

    _w = lambda a: (lambda t: t.to(torch.bfloat16) if t.is_floating_point() else t)(torch.as_tensor(a))
    B, Hq, Hkv, T, C, D = (8, 32, 8, 1, 4096, 128)
    tree_mask = torch.zeros((B, T, T), dtype=float)
    for b in range(B):
        parent = torch.zeros(T, dtype=torch.int64)
        for i in range(1, T):
            parent[i] = int(torch.randint(0, i, (1,)).item())
        for i in range(T):
            j = i
            tree_mask[b, i, j] = 1.0
            while j > 0:
                j = parent[j]
                tree_mask[b, i, j] = 1.0
    return {'q': _w((lambda *s: torch.randn(*s, dtype=torch.bfloat16) * 0.8)(B, Hq, T, D)), 'k_cache': _w((lambda *s: torch.randn(*s, dtype=torch.bfloat16) * 0.8)(B, Hkv, C, D)), 'v_cache': _w((lambda *s: torch.randn(*s, dtype=torch.bfloat16) * 0.05)(B, Hkv, C, D)), 'k_tree': _w((lambda *s: torch.randn(*s, dtype=torch.bfloat16) * 0.8)(B, Hkv, T, D)), 'v_tree': _w((lambda *s: torch.randn(*s, dtype=torch.bfloat16) * 0.05)(B, Hkv, T, D)), 'tree_mask': _w(tree_mask)}

def reference(q, k_cache, v_cache, k_tree, v_tree, tree_mask):
    B, Hq, T, D = q.shape
    Hkv, C = (k_cache.shape[1], k_cache.shape[2])
    rep = Hq // Hkv
    kc = (lambda x, n, axis: torch.repeat_interleave(x, n, dim=axis))(k_cache, rep, axis=1)
    vc = (lambda x, n, axis: torch.repeat_interleave(x, n, dim=axis))(v_cache, rep, axis=1)
    kt = (lambda x, n, axis: torch.repeat_interleave(x, n, dim=axis))(k_tree, rep, axis=1)
    vt = (lambda x, n, axis: torch.repeat_interleave(x, n, dim=axis))(v_tree, rep, axis=1)
    k = torch.concatenate([kc, kt], axis=2)
    v = torch.concatenate([vc, vt], axis=2)
    scale = D ** (-0.5)
    scores = torch.einsum('bhqd,bhkd->bhqk', q, k) * scale
    ctx_mask = torch.ones((B, 1, T, C), dtype=scores.dtype)
    tm = tree_mask[:, None, :, :].clone()
    full_mask = torch.concatenate([ctx_mask, tm], axis=-1)
    scores = scores + (1.0 - full_mask) * -1000000000.0
    p = _softmax(scores, axis=-1)
    return torch.einsum('bhqk,bhkd->bhqd', p, v)
```

```asm
; @launch grid=(256,1,1) block=(320,1,1) lds=49920
.amdgcn_target "amdgcn-amd-amdhsa--gfx950"
.text
.globl standalone__tree_speculative_verify_tree_attention_over_candidate_token_tree__decode_kernel
.p2align 8
.type standalone__tree_speculative_verify_tree_attention_over_candidate_token_tree__decode_kernel,@function
standalone__tree_speculative_verify_tree_attention_over_candidate_token_tree__decode_kernel:
    s_cmp_ge_u32 s2, 0x100
    s_cbranch_scc1 L_end
    s_load_dwordx16 s[4:19], s[0:1], 0
    v_lshrrev_b32 v2, 6, v0
    v_and_b32 v1, 63, v0
    v_bfe_u32 v3, v0, 4, 2
    v_readfirstlane_b32 s60, v2
    v_and_b32 v4, 15, v0
    s_and_b32 s69, s2, 7
    s_lshl_b32 s69, s69, 5
    s_lshr_b32 s64, s2, 3
    s_add_u32 s69, s69, s64
    s_lshr_b32 s63, s69, 2
    s_and_b32 s22, s69, 3
    s_cmp_eq_u32 s60, 4
    s_cbranch_scc1 L_helper
    v_xor_b32 v6, v3, v4
    v_lshlrev_b32 v5, 8, v3
    v_lshl_add_u32 v12, v6, 4, v5
    s_lshl_b32 s61, s69, 18
    s_lshl_b32 s64, s60, 12
    v_xor_b32 v13, 64, v12
    v_xor_b32 v14, 128, v12
    v_xor_b32 v15, 192, v12
    s_add_u32 s61, s61, s64
    s_mul_i32 s62, s60, 12288
    s_mov_b32 s30, 0x4000000
    s_mov_b32 s31, 0x20000
    s_mov_b32 s26, 0x10000
    s_mov_b32 s27, 0x20000
    s_mov_b32 m0, s62
    s_mov_b32 s67, s61
    s_lshl_b32 s65, s63, 10
    v_lshlrev_b32 v7, 8, v4
    v_cmp_gt_u32 vcc, 4, v4
    v_lshl_add_u32 v7, v3, 4, v7
    v_mov_b32 v8, 0x40000000
    v_add_u32 v7, s65, v7
    v_cndmask_b32 v7, v8, v7, vcc
    s_waitcnt lgkmcnt(0)
    s_mov_b32 s28, s6
    s_and_b32 s29, s7, 0xffff
    buffer_load_dwordx4 v12, s[28:31], s67 offen nt lds
    buffer_load_dwordx4 v13, s[28:31], s67 offen offset:1024 nt lds
    buffer_load_dwordx4 v14, s[28:31], s67 offen offset:2048 nt lds
    buffer_load_dwordx4 v15, s[28:31], s67 offen offset:3072 nt lds
    s_load_dwordx2 s[20:21], s[0:1], 64
    s_mov_b32 s24, s4
    s_and_b32 s25, s5, 0xffff
    buffer_load_dwordx4 v[32:35], v7, s[24:27], 0 offen
    buffer_load_dwordx4 v[36:39], v7, s[24:27], 0 offen offset:64
    buffer_load_dwordx4 v[40:43], v7, s[24:27], 0 offen offset:128
    buffer_load_dwordx4 v[44:47], v7, s[24:27], 0 offen offset:192
    s_add_u32 s67, s61, 16384
    s_add_u32 m0, s62, 4096
    s_nop 0
    buffer_load_dwordx4 v12, s[28:31], s67 offen nt lds
    buffer_load_dwordx4 v13, s[28:31], s67 offen offset:1024 nt lds
    buffer_load_dwordx4 v14, s[28:31], s67 offen offset:2048 nt lds
    buffer_load_dwordx4 v15, s[28:31], s67 offen offset:3072 nt lds
    s_add_u32 s67, s61, 32768
    s_add_u32 m0, s62, 8192
    s_nop 0
    buffer_load_dwordx4 v12, s[28:31], s67 offen nt lds
    buffer_load_dwordx4 v13, s[28:31], s67 offen offset:1024 nt lds
    buffer_load_dwordx4 v14, s[28:31], s67 offen offset:2048 nt lds
    buffer_load_dwordx4 v15, s[28:31], s67 offen offset:3072 nt lds
    s_sub_u32 s64, s22, s60
    s_sub_u32 s64, s64, 1
    s_and_b32 s64, s64, 3
    s_lshl_b32 s65, s63, 2
    s_add_u32 s65, s65, s60
    s_lshl_b32 s65, s65, 2
    s_add_u32 s64, s64, s65
    s_lshl_b32 s64, s64, 10
    s_lshl_b32 s65, s69, 12
    s_cmp_eq_u32 s60, s22
    s_cselect_b32 s90, s65, s64
    s_mov_b32 s32, s8
    s_and_b32 s33, s9, 0xffff
    s_mov_b32 s34, 0x4000000
    s_mov_b32 s35, 0x20000
    s_mov_b32 s40, s16
    s_and_b32 s41, s17, 0xffff
    s_mov_b32 s42, 0x10000
    s_mov_b32 s43, 0x20000
    s_mov_b32 s68, 0x3e0293ee
    s_getreg_b32 s91, hwreg(HW_REG_XCC_ID, 0, 4)
    v_lshlrev_b32 v6, 2, v3
    v_xor_b32 v6, v6, v4
    v_lshl_add_u32 v16, v6, 4, v5
    v_xor_b32 v6, v3, v4
    v_lshlrev_b32 v10, 8, v4
    v_lshl_add_u32 v10, v6, 4, v10
    v_add_u32 v18, s62, v10
    v_xor_b32 v19, 64, v18
    v_xor_b32 v20, 128, v18
    v_xor_b32 v21, 192, v18
    v_lshrrev_b32 v6, 2, v4
    v_lshlrev_b32 v9, 8, v6
    v_lshlrev_b32 v6, 1, v6
    v_xor_b32 v6, v6, v3
    v_lshl_add_u32 v9, v6, 5, v9
    v_and_b32 v10, 3, v4
    v_lshl_add_u32 v9, v10, 3, v9
    v_add_u32 v22, s62, v9
    v_xor_b32 v23, 128, v22
    v_mov_b32 v88, 0
    v_mov_b32 v89, 0
    v_mov_b32 v90, 0
    v_mov_b32 v91, 0
    v_mov_b32 v92, 0
    v_mov_b32 v93, 0
    v_mov_b32 v94, 0
    v_mov_b32 v95, 0
    s_waitcnt vmcnt(8)
    ds_read_b128 v[52:55], v18 offset:0
    ds_read_b128 v[56:59], v19 offset:0
    ds_read_b128 v[60:63], v20 offset:0
    ds_read_b128 v[64:67], v21 offset:0
    s_add_u32 s67, s61, 49152
    s_add_u32 m0, s62, 0
    s_waitcnt lgkmcnt(0)
    buffer_load_dwordx4 v12, s[28:31], s67 offen nt lds
    buffer_load_dwordx4 v13, s[28:31], s67 offen offset:1024 nt lds
    buffer_load_dwordx4 v14, s[28:31], s67 offen offset:2048 nt lds
    buffer_load_dwordx4 v15, s[28:31], s67 offen offset:3072 nt lds
    v_mfma_f32_16x16x32_bf16 v[96:99], v[52:55], v[32:35], 0
    v_mfma_f32_16x16x32_bf16 v[96:99], v[56:59], v[36:39], v[96:99]
    v_mfma_f32_16x16x32_bf16 v[96:99], v[60:63], v[40:43], v[96:99]
    v_mfma_f32_16x16x32_bf16 v[96:99], v[64:67], v[44:47], v[96:99]
    s_waitcnt vmcnt(8)
    ds_read_b128 v[52:55], v18 offset:4096
    ds_read_b128 v[56:59], v19 offset:4096
    ds_read_b128 v[60:63], v20 offset:4096
    ds_read_b128 v[64:67], v21 offset:4096
    s_add_u32 s67, s61, 65536
    s_add_u32 m0, s62, 4096
    s_nop 1
    v_max3_f32 v86, v96, v97, v98
    v_max_f32 v86, v86, v99
    s_waitcnt lgkmcnt(0)
    buffer_load_dwordx4 v12, s[28:31], s67 offen nt lds
    buffer_load_dwordx4 v13, s[28:31], s67 offen offset:1024 nt lds
    buffer_load_dwordx4 v14, s[28:31], s67 offen offset:2048 nt lds
    buffer_load_dwordx4 v15, s[28:31], s67 offen offset:3072 nt lds
    v_mfma_f32_16x16x32_bf16 v[100:103], v[52:55], v[32:35], 0
    v_mfma_f32_16x16x32_bf16 v[100:103], v[56:59], v[36:39], v[100:103]
    v_mfma_f32_16x16x32_bf16 v[100:103], v[60:63], v[40:43], v[100:103]
    v_mfma_f32_16x16x32_bf16 v[100:103], v[64:67], v[44:47], v[100:103]
    s_waitcnt vmcnt(8)
    ds_read_b128 v[52:55], v18 offset:8192
    ds_read_b128 v[56:59], v19 offset:8192
    ds_read_b128 v[60:63], v20 offset:8192
    ds_read_b128 v[64:67], v21 offset:8192
    s_add_u32 s67, s61, 81920
    s_add_u32 m0, s62, 8192
    s_nop 1
    v_max3_f32 v86, v86, v100, v101
    v_max3_f32 v86, v86, v102, v103
    s_waitcnt lgkmcnt(0)
    buffer_load_dwordx4 v12, s[28:31], s67 offen nt lds
    buffer_load_dwordx4 v13, s[28:31], s67 offen offset:1024 nt lds
    buffer_load_dwordx4 v14, s[28:31], s67 offen offset:2048 nt lds
    buffer_load_dwordx4 v15, s[28:31], s67 offen offset:3072 nt lds
    v_mfma_f32_16x16x32_bf16 v[104:107], v[52:55], v[32:35], 0
    v_mfma_f32_16x16x32_bf16 v[104:107], v[56:59], v[36:39], v[104:107]
    v_mfma_f32_16x16x32_bf16 v[104:107], v[60:63], v[40:43], v[104:107]
    v_mfma_f32_16x16x32_bf16 v[104:107], v[64:67], v[44:47], v[104:107]
    s_waitcnt vmcnt(8)
    ds_read_b128 v[52:55], v18 offset:0
    ds_read_b128 v[56:59], v19 offset:0
    ds_read_b128 v[60:63], v20 offset:0
    ds_read_b128 v[64:67], v21 offset:0
    s_add_u32 s67, s61, 98304
    s_add_u32 m0, s62, 0
    s_nop 1
    v_max3_f32 v86, v86, v104, v105
    v_max3_f32 v86, v86, v106, v107
    s_waitcnt lgkmcnt(0)
    buffer_load_dwordx4 v12, s[28:31], s67 offen nt lds
    buffer_load_dwordx4 v13, s[28:31], s67 offen offset:1024 nt lds
    buffer_load_dwordx4 v14, s[28:31], s67 offen offset:2048 nt lds
    buffer_load_dwordx4 v15, s[28:31], s67 offen offset:3072 nt lds
    v_mfma_f32_16x16x32_bf16 v[108:111], v[52:55], v[32:35], 0
    v_mfma_f32_16x16x32_bf16 v[108:111], v[56:59], v[36:39], v[108:111]
    v_mfma_f32_16x16x32_bf16 v[108:111], v[60:63], v[40:43], v[108:111]
    v_mfma_f32_16x16x32_bf16 v[108:111], v[64:67], v[44:47], v[108:111]
    s_waitcnt vmcnt(8)
    ds_read_b128 v[52:55], v18 offset:4096
    ds_read_b128 v[56:59], v19 offset:4096
    ds_read_b128 v[60:63], v20 offset:4096
    ds_read_b128 v[64:67], v21 offset:4096
    s_add_u32 s67, s61, 114688
    s_add_u32 m0, s62, 4096
    s_nop 1
    v_max3_f32 v86, v86, v108, v109
    v_max3_f32 v86, v86, v110, v111
    s_waitcnt lgkmcnt(0)
    buffer_load_dwordx4 v12, s[28:31], s67 offen nt lds
    buffer_load_dwordx4 v13, s[28:31], s67 offen offset:1024 nt lds
    buffer_load_dwordx4 v14, s[28:31], s67 offen offset:2048 nt lds
    buffer_load_dwordx4 v15, s[28:31], s67 offen offset:3072 nt lds
    v_mfma_f32_16x16x32_bf16 v[112:115], v[52:55], v[32:35], 0
    v_mfma_f32_16x16x32_bf16 v[112:115], v[56:59], v[36:39], v[112:115]
    v_mfma_f32_16x16x32_bf16 v[112:115], v[60:63], v[40:43], v[112:115]
    v_mfma_f32_16x16x32_bf16 v[112:115], v[64:67], v[44:47], v[112:115]
    s_waitcnt vmcnt(8)
    ds_read_b128 v[52:55], v18 offset:8192
    ds_read_b128 v[56:59], v19 offset:8192
    ds_read_b128 v[60:63], v20 offset:8192
    ds_read_b128 v[64:67], v21 offset:8192
    s_add_u32 s67, s61, 131072
    s_add_u32 m0, s62, 8192
    s_nop 1
    v_max3_f32 v86, v86, v112, v113
    v_max3_f32 v86, v86, v114, v115
    s_waitcnt lgkmcnt(0)
    buffer_load_dwordx4 v12, s[28:31], s67 offen nt lds
    buffer_load_dwordx4 v13, s[28:31], s67 offen offset:1024 nt lds
    buffer_load_dwordx4 v14, s[28:31], s67 offen offset:2048 nt lds
    buffer_load_dwordx4 v15, s[28:31], s67 offen offset:3072 nt lds
    v_mfma_f32_16x16x32_bf16 v[116:119], v[52:55], v[32:35], 0
    v_mfma_f32_16x16x32_bf16 v[116:119], v[56:59], v[36:39], v[116:119]
    v_mfma_f32_16x16x32_bf16 v[116:119], v[60:63], v[40:43], v[116:119]
    v_mfma_f32_16x16x32_bf16 v[116:119], v[64:67], v[44:47], v[116:119]
    s_waitcnt vmcnt(8)
    ds_read_b128 v[52:55], v18 offset:0
    ds_read_b128 v[56:59], v19 offset:0
    ds_read_b128 v[60:63], v20 offset:0
    ds_read_b128 v[64:67], v21 offset:0
    s_add_u32 s67, s61, 147456
    s_add_u32 m0, s62, 0
    s_nop 1
    v_max3_f32 v86, v86, v116, v117
    v_max3_f32 v86, v86, v118, v119
    s_waitcnt lgkmcnt(0)
    buffer_load_dwordx4 v12, s[28:31], s67 offen nt lds
    buffer_load_dwordx4 v13, s[28:31], s67 offen offset:1024 nt lds
    buffer_load_dwordx4 v14, s[28:31], s67 offen offset:2048 nt lds
    buffer_load_dwordx4 v15, s[28:31], s67 offen offset:3072 nt lds
    v_mfma_f32_16x16x32_bf16 v[120:123], v[52:55], v[32:35], 0
    v_mfma_f32_16x16x32_bf16 v[120:123], v[56:59], v[36:39], v[120:123]
    v_mfma_f32_16x16x32_bf16 v[120:123], v[60:63], v[40:43], v[120:123]
    v_mfma_f32_16x16x32_bf16 v[120:123], v[64:67], v[44:47], v[120:123]
    s_waitcnt vmcnt(8)
    ds_read_b128 v[52:55], v18 offset:4096
    ds_read_b128 v[56:59], v19 offset:4096
    ds_read_b128 v[60:63], v20 offset:4096
    ds_read_b128 v[64:67], v21 offset:4096
    s_add_u32 s67, s61, 163840
    s_add_u32 m0, s62, 4096
    s_nop 1
    v_max3_f32 v86, v86, v120, v121
    v_max3_f32 v86, v86, v122, v123
    s_waitcnt lgkmcnt(0)
    buffer_load_dwordx4 v12, s[28:31], s67 offen nt lds
    buffer_load_dwordx4 v13, s[28:31], s67 offen offset:1024 nt lds
    buffer_load_dwordx4 v14, s[28:31], s67 offen offset:2048 nt lds
    buffer_load_dwordx4 v15, s[28:31], s67 offen offset:3072 nt lds
    v_mfma_f32_16x16x32_bf16 v[124:127], v[52:55], v[32:35], 0
    v_mfma_f32_16x16x32_bf16 v[124:127], v[56:59], v[36:39], v[124:127]
    v_mfma_f32_16x16x32_bf16 v[124:127], v[60:63], v[40:43], v[124:127]
    v_mfma_f32_16x16x32_bf16 v[124:127], v[64:67], v[44:47], v[124:127]
    s_waitcnt vmcnt(8)
    ds_read_b128 v[52:55], v18 offset:8192
    ds_read_b128 v[56:59], v19 offset:8192
    ds_read_b128 v[60:63], v20 offset:8192
    ds_read_b128 v[64:67], v21 offset:8192
    s_add_u32 s67, s61, 180224
    s_add_u32 m0, s62, 8192
    s_nop 1
    v_max3_f32 v86, v86, v124, v125
    v_max3_f32 v86, v86, v126, v127
    s_waitcnt lgkmcnt(0)
    buffer_load_dwordx4 v12, s[28:31], s67 offen nt lds
    buffer_load_dwordx4 v13, s[28:31], s67 offen offset:1024 nt lds
    buffer_load_dwordx4 v14, s[28:31], s67 offen offset:2048 nt lds
    buffer_load_dwordx4 v15, s[28:31], s67 offen offset:3072 nt lds
    v_mfma_f32_16x16x32_bf16 v[128:131], v[52:55], v[32:35], 0
    v_mfma_f32_16x16x32_bf16 v[128:131], v[56:59], v[36:39], v[128:131]
    v_mfma_f32_16x16x32_bf16 v[128:131], v[60:63], v[40:43], v[128:131]
    v_mfma_f32_16x16x32_bf16 v[128:131], v[64:67], v[44:47], v[128:131]
    v_mov_b32 v6, 49160
    v_mov_b32 v7, 0x5eed1e57
    ds_write_b32 v6, v7
    s_waitcnt vmcnt(8)
    ds_read_b128 v[52:55], v18 offset:0
    ds_read_b128 v[56:59], v19 offset:0
    ds_read_b128 v[60:63], v20 offset:0
    ds_read_b128 v[64:67], v21 offset:0
    s_add_u32 s67, s61, 196608
    s_add_u32 m0, s62, 0
    s_nop 1
    v_max3_f32 v86, v86, v128, v129
    v_max3_f32 v86, v86, v130, v131
    s_waitcnt lgkmcnt(0)
    buffer_load_dwordx4 v12, s[28:31], s67 offen nt lds
    buffer_load_dwordx4 v13, s[28:31], s67 offen offset:1024 nt lds
    buffer_load_dwordx4 v14, s[28:31], s67 offen offset:2048 nt lds
    buffer_load_dwordx4 v15, s[28:31], s67 offen offset:3072 nt lds
    v_mfma_f32_16x16x32_bf16 v[132:135], v[52:55], v[32:35], 0
    v_mfma_f32_16x16x32_bf16 v[132:135], v[56:59], v[36:39], v[132:135]
    v_mfma_f32_16x16x32_bf16 v[132:135], v[60:63], v[40:43], v[132:135]
    v_mfma_f32_16x16x32_bf16 v[132:135], v[64:67], v[44:47], v[132:135]
    s_waitcnt vmcnt(8)
    ds_read_b128 v[52:55], v18 offset:4096
    ds_read_b128 v[56:59], v19 offset:4096
    ds_read_b128 v[60:63], v20 offset:4096
    ds_read_b128 v[64:67], v21 offset:4096
    s_add_u32 s67, s61, 212992
    s_add_u32 m0, s62, 4096
    s_nop 1
    v_max3_f32 v86, v86, v132, v133
    v_max3_f32 v86, v86, v134, v135
    s_waitcnt lgkmcnt(0)
    buffer_load_dwordx4 v12, s[28:31], s67 offen nt lds
    buffer_load_dwordx4 v13, s[28:31], s67 offen offset:1024 nt lds
    buffer_load_dwordx4 v14, s[28:31], s67 offen offset:2048 nt lds
    buffer_load_dwordx4 v15, s[28:31], s67 offen offset:3072 nt lds
    v_mfma_f32_16x16x32_bf16 v[136:139], v[52:55], v[32:35], 0
    v_mfma_f32_16x16x32_bf16 v[136:139], v[56:59], v[36:39], v[136:139]
    v_mfma_f32_16x16x32_bf16 v[136:139], v[60:63], v[40:43], v[136:139]
    v_mfma_f32_16x16x32_bf16 v[136:139], v[64:67], v[44:47], v[136:139]
    s_waitcnt vmcnt(8)
    ds_read_b128 v[52:55], v18 offset:8192
    ds_read_b128 v[56:59], v19 offset:8192
    ds_read_b128 v[60:63], v20 offset:8192
    ds_read_b128 v[64:67], v21 offset:8192
    s_add_u32 s67, s61, 229376
    s_add_u32 m0, s62, 8192
    s_nop 1
    v_max3_f32 v86, v86, v136, v137
    v_max3_f32 v86, v86, v138, v139
    s_waitcnt lgkmcnt(0)
    buffer_load_dwordx4 v12, s[28:31], s67 offen nt lds
    buffer_load_dwordx4 v13, s[28:31], s67 offen offset:1024 nt lds
    buffer_load_dwordx4 v14, s[28:31], s67 offen offset:2048 nt lds
    buffer_load_dwordx4 v15, s[28:31], s67 offen offset:3072 nt lds
    v_mfma_f32_16x16x32_bf16 v[140:143], v[52:55], v[32:35], 0
    v_mfma_f32_16x16x32_bf16 v[140:143], v[56:59], v[36:39], v[140:143]
    v_mfma_f32_16x16x32_bf16 v[140:143], v[60:63], v[40:43], v[140:143]
    v_mfma_f32_16x16x32_bf16 v[140:143], v[64:67], v[44:47], v[140:143]
    s_waitcnt vmcnt(8)
    ds_read_b128 v[52:55], v18 offset:0
    ds_read_b128 v[56:59], v19 offset:0
    ds_read_b128 v[60:63], v20 offset:0
    ds_read_b128 v[64:67], v21 offset:0
    s_add_u32 s67, s61, 245760
    s_add_u32 m0, s62, 0
    s_nop 1
    v_max3_f32 v86, v86, v140, v141
    v_max3_f32 v86, v86, v142, v143
    s_waitcnt lgkmcnt(0)
    buffer_load_dwordx4 v12, s[28:31], s67 offen nt lds
    buffer_load_dwordx4 v13, s[28:31], s67 offen offset:1024 nt lds
    buffer_load_dwordx4 v14, s[28:31], s67 offen offset:2048 nt lds
    buffer_load_dwordx4 v15, s[28:31], s67 offen offset:3072 nt lds
    v_mfma_f32_16x16x32_bf16 v[144:147], v[52:55], v[32:35], 0
    v_mfma_f32_16x16x32_bf16 v[144:147], v[56:59], v[36:39], v[144:147]
    v_mfma_f32_16x16x32_bf16 v[144:147], v[60:63], v[40:43], v[144:147]
    v_mfma_f32_16x16x32_bf16 v[144:147], v[64:67], v[44:47], v[144:147]
    s_waitcnt vmcnt(8)
    ds_read_b128 v[52:55], v18 offset:4096
    ds_read_b128 v[56:59], v19 offset:4096
    ds_read_b128 v[60:63], v20 offset:4096
    ds_read_b128 v[64:67], v21 offset:4096
    s_add_u32 s67, s61, 0
    s_add_u32 m0, s62, 4096
    s_nop 1
    v_max3_f32 v86, v86, v144, v145
    v_max3_f32 v86, v86, v146, v147
    s_waitcnt lgkmcnt(0)
    buffer_load_dwordx4 v16, s[32:35], s67 offen nt lds
    buffer_load_dwordx4 v16, s[32:35], s67 offen offset:1024 nt lds
    buffer_load_dwordx4 v16, s[32:35], s67 offen offset:2048 nt lds
    buffer_load_dwordx4 v16, s[32:35], s67 offen offset:3072 nt lds
    v_mfma_f32_16x16x32_bf16 v[148:151], v[52:55], v[32:35], 0
    v_mfma_f32_16x16x32_bf16 v[148:151], v[56:59], v[36:39], v[148:151]
    v_mfma_f32_16x16x32_bf16 v[148:151], v[60:63], v[40:43], v[148:151]
    v_mfma_f32_16x16x32_bf16 v[148:151], v[64:67], v[44:47], v[148:151]
    s_waitcnt vmcnt(8)
    ds_read_b128 v[52:55], v18 offset:8192
    ds_read_b128 v[56:59], v19 offset:8192
    ds_read_b128 v[60:63], v20 offset:8192
    ds_read_b128 v[64:67], v21 offset:8192
    s_add_u32 s67, s61, 16384
    s_add_u32 m0, s62, 8192
    s_nop 1
    v_max3_f32 v86, v86, v148, v149
    v_max3_f32 v86, v86, v150, v151
    s_waitcnt lgkmcnt(0)
    buffer_load_dwordx4 v16, s[32:35], s67 offen nt lds
    buffer_load_dwordx4 v16, s[32:35], s67 offen offset:1024 nt lds
    buffer_load_dwordx4 v16, s[32:35], s67 offen offset:2048 nt lds
    buffer_load_dwordx4 v16, s[32:35], s67 offen offset:3072 nt lds
    v_mfma_f32_16x16x32_bf16 v[152:155], v[52:55], v[32:35], 0
    v_mfma_f32_16x16x32_bf16 v[152:155], v[56:59], v[36:39], v[152:155]
    v_mfma_f32_16x16x32_bf16 v[152:155], v[60:63], v[40:43], v[152:155]
    v_mfma_f32_16x16x32_bf16 v[152:155], v[64:67], v[44:47], v[152:155]
    s_waitcnt vmcnt(8)
    ds_read_b128 v[52:55], v18 offset:0
    ds_read_b128 v[56:59], v19 offset:0
    ds_read_b128 v[60:63], v20 offset:0
    ds_read_b128 v[64:67], v21 offset:0
    s_add_u32 s67, s61, 32768
    s_add_u32 m0, s62, 0
    s_nop 1
    v_max3_f32 v86, v86, v152, v153
    v_max3_f32 v86, v86, v154, v155
    s_waitcnt lgkmcnt(0)
    buffer_load_dwordx4 v16, s[32:35], s67 offen nt lds
    buffer_load_dwordx4 v16, s[32:35], s67 offen offset:1024 nt lds
    buffer_load_dwordx4 v16, s[32:35], s67 offen offset:2048 nt lds
    buffer_load_dwordx4 v16, s[32:35], s67 offen offset:3072 nt lds
    v_mfma_f32_16x16x32_bf16 v[156:159], v[52:55], v[32:35], 0
    v_mfma_f32_16x16x32_bf16 v[156:159], v[56:59], v[36:39], v[156:159]
    v_mfma_f32_16x16x32_bf16 v[156:159], v[60:63], v[40:43], v[156:159]
    v_mfma_f32_16x16x32_bf16 v[156:159], v[64:67], v[44:47], v[156:159]
    s_mov_b32 s44, s20
    s_and_b32 s45, s21, 0xffff
    s_mov_b32 s46, 0x108000
    s_mov_b32 s47, 0x20000
    s_nop 3
    v_max3_f32 v86, v86, v156, v157
    v_max3_f32 v86, v86, v158, v159
    v_mov_b32 v2, v86
    s_nop 1
    v_permlane16_swap_b32 v86, v2
    v_max_f32 v86, v86, v2
    v_mov_b32 v2, v86
    s_nop 1
    v_permlane32_swap_b32 v86, v2
    v_max_f32 v86, v86, v2
    v_mul_f32 v86, s68, v86
    v_mov_b32 v87, 0
    v_fma_f32 v96, v96, s68, -v86
    v_fma_f32 v97, v97, s68, -v86
    v_fma_f32 v98, v98, s68, -v86
    v_fma_f32 v99, v99, s68, -v86
    v_exp_f32 v96, v96
    v_exp_f32 v97, v97
    v_exp_f32 v98, v98
    v_exp_f32 v99, v99
    s_nop 0
    v_add_f32 v87, v87, v96
    v_cvt_pk_bf16_f32 v84, v96, v97
    v_add_f32 v87, v87, v97
    v_add_f32 v87, v87, v98
    v_cvt_pk_bf16_f32 v85, v98, v99
    v_add_f32 v87, v87, v99
    s_waitcnt vmcnt(8)
    ds_read_b64_tr_b16 v[68:69], v22 offset:4096
    ds_read_b64_tr_b16 v[70:71], v23 offset:4096
    ds_read_b64_tr_b16 v[72:73], v22 offset:5120
    ds_read_b64_tr_b16 v[74:75], v23 offset:5120
    ds_read_b64_tr_b16 v[76:77], v22 offset:6144
    ds_read_b64_tr_b16 v[78:79], v23 offset:6144
    ds_read_b64_tr_b16 v[80:81], v22 offset:7168
    ds_read_b64_tr_b16 v[82:83], v23 offset:7168
    s_add_u32 s67, s61, 49152
    s_add_u32 m0, s62, 4096
    s_waitcnt lgkmcnt(0)
    buffer_load_dwordx4 v16, s[32:35], s67 offen nt lds
    buffer_load_dwordx4 v16, s[32:35], s67 offen offset:1024 nt lds
    buffer_load_dwordx4 v16, s[32:35], s67 offen offset:2048 nt lds
    buffer_load_dwordx4 v16, s[32:35], s67 offen offset:3072 nt lds
    v_mfma_f32_4x4x4_16b_bf16 v[88:91], v[84:85], v[68:69], v[88:91] cbsz:4 abid:0
    v_mfma_f32_4x4x4_16b_bf16 v[92:95], v[84:85], v[70:71], v[92:95] cbsz:4 abid:0
    s_nop 0
    v_mfma_f32_4x4x4_16b_bf16 v[88:91], v[84:85], v[72:73], v[88:91] cbsz:4 abid:4
    v_mfma_f32_4x4x4_16b_bf16 v[92:95], v[84:85], v[74:75], v[92:95] cbsz:4 abid:4
    s_nop 0
    v_mfma_f32_4x4x4_16b_bf16 v[88:91], v[84:85], v[76:77], v[88:91] cbsz:4 abid:8
    v_mfma_f32_4x4x4_16b_bf16 v[92:95], v[84:85], v[78:79], v[92:95] cbsz:4 abid:8
    s_nop 0
    v_mfma_f32_4x4x4_16b_bf16 v[88:91], v[84:85], v[80:81], v[88:91] cbsz:4 abid:12
    v_mfma_f32_4x4x4_16b_bf16 v[92:95], v[84:85], v[82:83], v[92:95] cbsz:4 abid:12
    v_fma_f32 v100, v100, s68, -v86
    v_fma_f32 v101, v101, s68, -v86
    v_fma_f32 v102, v102, s68, -v86
    v_fma_f32 v103, v103, s68, -v86
    v_exp_f32 v100, v100
    v_exp_f32 v101, v101
    v_exp_f32 v102, v102
    v_exp_f32 v103, v103
    s_nop 0
    v_add_f32 v87, v87, v100
    v_cvt_pk_bf16_f32 v84, v100, v101
    v_add_f32 v87, v87, v101
    v_add_f32 v87, v87, v102
    v_cvt_pk_bf16_f32 v85, v102, v103
    v_add_f32 v87, v87, v103
    s_waitcnt vmcnt(8)
    ds_read_b64_tr_b16 v[68:69], v22 offset:8192
    ds_read_b64_tr_b16 v[70:71], v23 offset:8192
    ds_read_b64_tr_b16 v[72:73], v22 offset:9216
    ds_read_b64_tr_b16 v[74:75], v23 offset:9216
    ds_read_b64_tr_b16 v[76:77], v22 offset:10240
    ds_read_b64_tr_b16 v[78:79], v23 offset:10240
    ds_read_b64_tr_b16 v[80:81], v22 offset:11264
    ds_read_b64_tr_b16 v[82:83], v23 offset:11264
    s_add_u32 s67, s61, 65536
    s_add_u32 m0, s62, 8192
    s_waitcnt lgkmcnt(0)
    buffer_load_dwordx4 v16, s[32:35], s67 offen nt lds
    buffer_load_dwordx4 v16, s[32:35], s67 offen offset:1024 nt lds
    buffer_load_dwordx4 v16, s[32:35], s67 offen offset:2048 nt lds
    buffer_load_dwordx4 v16, s[32:35], s67 offen offset:3072 nt lds
    v_mfma_f32_4x4x4_16b_bf16 v[88:91], v[84:85], v[68:69], v[88:91] cbsz:4 abid:0
    v_mfma_f32_4x4x4_16b_bf16 v[92:95], v[84:85], v[70:71], v[92:95] cbsz:4 abid:0
    s_nop 0
    v_mfma_f32_4x4x4_16b_bf16 v[88:91], v[84:85], v[72:73], v[88:91] cbsz:4 abid:4
    v_mfma_f32_4x4x4_16b_bf16 v[92:95], v[84:85], v[74:75], v[92:95] cbsz:4 abid:4
    s_nop 0
    v_mfma_f32_4x4x4_16b_bf16 v[88:91], v[84:85], v[76:77], v[88:91] cbsz:4 abid:8
    v_mfma_f32_4x4x4_16b_bf16 v[92:95], v[84:85], v[78:79], v[92:95] cbsz:4 abid:8
    s_nop 0
    v_mfma_f32_4x4x4_16b_bf16 v[88:91], v[84:85], v[80:81], v[88:91] cbsz:4 abid:12
    v_mfma_f32_4x4x4_16b_bf16 v[92:95], v[84:85], v[82:83], v[92:95] cbsz:4 abid:12
    v_fma_f32 v104, v104, s68, -v86
    v_fma_f32 v105, v105, s68, -v86
    v_fma_f32 v106, v106, s68, -v86
    v_fma_f32 v107, v107, s68, -v86
    v_exp_f32 v104, v104
    v_exp_f32 v105, v105
    v_exp_f32 v106, v106
    v_exp_f32 v107, v107
    s_nop 0
    v_add_f32 v87, v87, v104
    v_cvt_pk_bf16_f32 v84, v104, v105
    v_add_f32 v87, v87, v105
    v_add_f32 v87, v87, v106
    v_cvt_pk_bf16_f32 v85, v106, v107
    v_add_f32 v87, v87, v107
    s_waitcnt vmcnt(8)
    ds_read_b64_tr_b16 v[68:69], v22 offset:0
    ds_read_b64_tr_b16 v[70:71], v23 offset:0
    ds_read_b64_tr_b16 v[72:73], v22 offset:1024
    ds_read_b64_tr_b16 v[74:75], v23 offset:1024
    ds_read_b64_tr_b16 v[76:77], v22 offset:2048
    ds_read_b64_tr_b16 v[78:79], v23 offset:2048
    ds_read_b64_tr_b16 v[80:81], v22 offset:3072
    ds_read_b64_tr_b16 v[82:83], v23 offset:3072
    s_add_u32 s67, s61, 81920
    s_add_u32 m0, s62, 0
    s_waitcnt lgkmcnt(0)
    buffer_load_dwordx4 v16, s[32:35], s67 offen nt lds
    buffer_load_dwordx4 v16, s[32:35], s67 offen offset:1024 nt lds
    buffer_load_dwordx4 v16, s[32:35], s67 offen offset:2048 nt lds
    buffer_load_dwordx4 v16, s[32:35], s67 offen offset:3072 nt lds
    v_mfma_f32_4x4x4_16b_bf16 v[88:91], v[84:85], v[68:69], v[88:91] cbsz:4 abid:0
    v_mfma_f32_4x4x4_16b_bf16 v[92:95], v[84:85], v[70:71], v[92:95] cbsz:4 abid:0
    s_nop 0
    v_mfma_f32_4x4x4_16b_bf16 v[88:91], v[84:85], v[72:73], v[88:91] cbsz:4 abid:4
    v_mfma_f32_4x4x4_16b_bf16 v[92:95], v[84:85], v[74:75], v[92:95] cbsz:4 abid:4
    s_nop 0
    v_mfma_f32_4x4x4_16b_bf16 v[88:91], v[84:85], v[76:77], v[88:91] cbsz:4 abid:8
    v_mfma_f32_4x4x4_16b_bf16 v[92:95], v[84:85], v[78:79], v[92:95] cbsz:4 abid:8
    s_nop 0
    v_mfma_f32_4x4x4_16b_bf16 v[88:91], v[84:85], v[80:81], v[88:91] cbsz:4 abid:12
    v_mfma_f32_4x4x4_16b_bf16 v[92:95], v[84:85], v[82:83], v[92:95] cbsz:4 abid:12
    v_fma_f32 v108, v108, s68, -v86
    v_fma_f32 v109, v109, s68, -v86
    v_fma_f32 v110, v110, s68, -v86
    v_fma_f32 v111, v111, s68, -v86
    v_exp_f32 v108, v108
    v_exp_f32 v109, v109
    v_exp_f32 v110, v110
    v_exp_f32 v111, v111
    s_nop 0
    v_add_f32 v87, v87, v108
    v_cvt_pk_bf16_f32 v84, v108, v109
    v_add_f32 v87, v87, v109
    v_add_f32 v87, v87, v110
    v_cvt_pk_bf16_f32 v85, v110, v111
    v_add_f32 v87, v87, v111
    s_waitcnt vmcnt(8)
    ds_read_b64_tr_b16 v[68:69], v22 offset:4096
    ds_read_b64_tr_b16 v[70:71], v23 offset:4096
    ds_read_b64_tr_b16 v[72:73], v22 offset:5120
    ds_read_b64_tr_b16 v[74:75], v23 offset:5120
    ds_read_b64_tr_b16 v[76:77], v22 offset:6144
    ds_read_b64_tr_b16 v[78:79], v23 offset:6144
    ds_read_b64_tr_b16 v[80:81], v22 offset:7168
    ds_read_b64_tr_b16 v[82:83], v23 offset:7168
    s_add_u32 s67, s61, 98304
    s_add_u32 m0, s62, 4096
    s_waitcnt lgkmcnt(0)
    buffer_load_dwordx4 v16, s[32:35], s67 offen nt lds
    buffer_load_dwordx4 v16, s[32:35], s67 offen offset:1024 nt lds
    buffer_load_dwordx4 v16, s[32:35], s67 offen offset:2048 nt lds
    buffer_load_dwordx4 v16, s[32:35], s67 offen offset:3072 nt lds
    v_mfma_f32_4x4x4_16b_bf16 v[88:91], v[84:85], v[68:69], v[88:91] cbsz:4 abid:0
    v_mfma_f32_4x4x4_16b_bf16 v[92:95], v[84:85], v[70:71], v[92:95] cbsz:4 abid:0
    s_nop 0
    v_mfma_f32_4x4x4_16b_bf16 v[88:91], v[84:85], v[72:73], v[88:91] cbsz:4 abid:4
    v_mfma_f32_4x4x4_16b_bf16 v[92:95], v[84:85], v[74:75], v[92:95] cbsz:4 abid:4
    s_nop 0
    v_mfma_f32_4x4x4_16b_bf16 v[88:91], v[84:85], v[76:77], v[88:91] cbsz:4 abid:8
    v_mfma_f32_4x4x4_16b_bf16 v[92:95], v[84:85], v[78:79], v[92:95] cbsz:4 abid:8
    s_nop 0
    v_mfma_f32_4x4x4_16b_bf16 v[88:91], v[84:85], v[80:81], v[88:91] cbsz:4 abid:12
    v_mfma_f32_4x4x4_16b_bf16 v[92:95], v[84:85], v[82:83], v[92:95] cbsz:4 abid:12
    v_fma_f32 v112, v112, s68, -v86
    v_fma_f32 v113, v113, s68, -v86
    v_fma_f32 v114, v114, s68, -v86
    v_fma_f32 v115, v115, s68, -v86
    v_exp_f32 v112, v112
    v_exp_f32 v113, v113
    v_exp_f32 v114, v114
    v_exp_f32 v115, v115
    s_nop 0
    v_add_f32 v87, v87, v112
    v_cvt_pk_bf16_f32 v84, v112, v113
    v_add_f32 v87, v87, v113
    v_add_f32 v87, v87, v114
    v_cvt_pk_bf16_f32 v85, v114, v115
    v_add_f32 v87, v87, v115
    s_waitcnt vmcnt(8)
    ds_read_b64_tr_b16 v[68:69], v22 offset:8192
    ds_read_b64_tr_b16 v[70:71], v23 offset:8192
    ds_read_b64_tr_b16 v[72:73], v22 offset:9216
    ds_read_b64_tr_b16 v[74:75], v23 offset:9216
    ds_read_b64_tr_b16 v[76:77], v22 offset:10240
    ds_read_b64_tr_b16 v[78:79], v23 offset:10240
    ds_read_b64_tr_b16 v[80:81], v22 offset:11264
    ds_read_b64_tr_b16 v[82:83], v23 offset:11264
    s_add_u32 s67, s61, 114688
    s_add_u32 m0, s62, 8192
    s_waitcnt lgkmcnt(0)
    buffer_load_dwordx4 v16, s[32:35], s67 offen nt lds
    buffer_load_dwordx4 v16, s[32:35], s67 offen offset:1024 nt lds
    buffer_load_dwordx4 v16, s[32:35], s67 offen offset:2048 nt lds
    buffer_load_dwordx4 v16, s[32:35], s67 offen offset:3072 nt lds
    v_mfma_f32_4x4x4_16b_bf16 v[88:91], v[84:85], v[68:69], v[88:91] cbsz:4 abid:0
    v_mfma_f32_4x4x4_16b_bf16 v[92:95], v[84:85], v[70:71], v[92:95] cbsz:4 abid:0
    s_nop 0
    v_mfma_f32_4x4x4_16b_bf16 v[88:91], v[84:85], v[72:73], v[88:91] cbsz:4 abid:4
    v_mfma_f32_4x4x4_16b_bf16 v[92:95], v[84:85], v[74:75], v[92:95] cbsz:4 abid:4
    s_nop 0
    v_mfma_f32_4x4x4_16b_bf16 v[88:91], v[84:85], v[76:77], v[88:91] cbsz:4 abid:8
    v_mfma_f32_4x4x4_16b_bf16 v[92:95], v[84:85], v[78:79], v[92:95] cbsz:4 abid:8
    s_nop 0
    v_mfma_f32_4x4x4_16b_bf16 v[88:91], v[84:85], v[80:81], v[88:91] cbsz:4 abid:12
    v_mfma_f32_4x4x4_16b_bf16 v[92:95], v[84:85], v[82:83], v[92:95] cbsz:4 abid:12
    v_fma_f32 v116, v116, s68, -v86
    v_fma_f32 v117, v117, s68, -v86
    v_fma_f32 v118, v118, s68, -v86
    v_fma_f32 v119, v119, s68, -v86
    v_exp_f32 v116, v116
    v_exp_f32 v117, v117
    v_exp_f32 v118, v118
    v_exp_f32 v119, v119
    s_nop 0
    v_add_f32 v87, v87, v116
    v_cvt_pk_bf16_f32 v84, v116, v117
    v_add_f32 v87, v87, v117
    v_add_f32 v87, v87, v118
    v_cvt_pk_bf16_f32 v85, v118, v119
    v_add_f32 v87, v87, v119
    s_waitcnt vmcnt(8)
    ds_read_b64_tr_b16 v[68:69], v22 offset:0
    ds_read_b64_tr_b16 v[70:71], v23 offset:0
    ds_read_b64_tr_b16 v[72:73], v22 offset:1024
    ds_read_b64_tr_b16 v[74:75], v23 offset:1024
    ds_read_b64_tr_b16 v[76:77], v22 offset:2048
    ds_read_b64_tr_b16 v[78:79], v23 offset:2048
    ds_read_b64_tr_b16 v[80:81], v22 offset:3072
    ds_read_b64_tr_b16 v[82:83], v23 offset:3072
    s_add_u32 s67, s61, 131072
    s_add_u32 m0, s62, 0
    s_waitcnt lgkmcnt(0)
    buffer_load_dwordx4 v16, s[32:35], s67 offen nt lds
    buffer_load_dwordx4 v16, s[32:35], s67 offen offset:1024 nt lds
    buffer_load_dwordx4 v16, s[32:35], s67 offen offset:2048 nt lds
    buffer_load_dwordx4 v16, s[32:35], s67 offen offset:3072 nt lds
    v_mfma_f32_4x4x4_16b_bf16 v[88:91], v[84:85], v[68:69], v[88:91] cbsz:4 abid:0
    v_mfma_f32_4x4x4_16b_bf16 v[92:95], v[84:85], v[70:71], v[92:95] cbsz:4 abid:0
    s_nop 0
    v_mfma_f32_4x4x4_16b_bf16 v[88:91], v[84:85], v[72:73], v[88:91] cbsz:4 abid:4
    v_mfma_f32_4x4x4_16b_bf16 v[92:95], v[84:85], v[74:75], v[92:95] cbsz:4 abid:4
    s_nop 0
    v_mfma_f32_4x4x4_16b_bf16 v[88:91], v[84:85], v[76:77], v[88:91] cbsz:4 abid:8
    v_mfma_f32_4x4x4_16b_bf16 v[92:95], v[84:85], v[78:79], v[92:95] cbsz:4 abid:8
    s_nop 0
    v_mfma_f32_4x4x4_16b_bf16 v[88:91], v[84:85], v[80:81], v[88:91] cbsz:4 abid:12
    v_mfma_f32_4x4x4_16b_bf16 v[92:95], v[84:85], v[82:83], v[92:95] cbsz:4 abid:12
    v_fma_f32 v120, v120, s68, -v86
    v_fma_f32 v121, v121, s68, -v86
    v_fma_f32 v122, v122, s68, -v86
    v_fma_f32 v123, v123, s68, -v86
    v_exp_f32 v120, v120
    v_exp_f32 v121, v121
    v_exp_f32 v122, v122
    v_exp_f32 v123, v123
    s_nop 0
    v_add_f32 v87, v87, v120
    v_cvt_pk_bf16_f32 v84, v120, v121
    v_add_f32 v87, v87, v121
    v_add_f32 v87, v87, v122
    v_cvt_pk_bf16_f32 v85, v122, v123
    v_add_f32 v87, v87, v123
    v_mov_b32 v6, 49160
    v_mov_b32 v7, 0x5eed1e58
    ds_write_b32 v6, v7
    s_waitcnt vmcnt(8)
    ds_read_b64_tr_b16 v[68:69], v22 offset:4096
    ds_read_b64_tr_b16 v[70:71], v23 offset:4096
    ds_read_b64_tr_b16 v[72:73], v22 offset:5120
    ds_read_b64_tr_b16 v[74:75], v23 offset:5120
    ds_read_b64_tr_b16 v[76:77], v22 offset:6144
    ds_read_b64_tr_b16 v[78:79], v23 offset:6144
    ds_read_b64_tr_b16 v[80:81], v22 offset:7168
    ds_read_b64_tr_b16 v[82:83], v23 offset:7168
    s_add_u32 s67, s61, 147456
    s_add_u32 m0, s62, 4096
    s_waitcnt lgkmcnt(0)
    buffer_load_dwordx4 v16, s[32:35], s67 offen nt lds
    buffer_load_dwordx4 v16, s[32:35], s67 offen offset:1024 nt lds
    buffer_load_dwordx4 v16, s[32:35], s67 offen offset:2048 nt lds
    buffer_load_dwordx4 v16, s[32:35], s67 offen offset:3072 nt lds
    v_mfma_f32_4x4x4_16b_bf16 v[88:91], v[84:85], v[68:69], v[88:91] cbsz:4 abid:0
    v_mfma_f32_4x4x4_16b_bf16 v[92:95], v[84:85], v[70:71], v[92:95] cbsz:4 abid:0
    s_nop 0
    v_mfma_f32_4x4x4_16b_bf16 v[88:91], v[84:85], v[72:73], v[88:91] cbsz:4 abid:4
    v_mfma_f32_4x4x4_16b_bf16 v[92:95], v[84:85], v[74:75], v[92:95] cbsz:4 abid:4
    s_nop 0
    v_mfma_f32_4x4x4_16b_bf16 v[88:91], v[84:85], v[76:77], v[88:91] cbsz:4 abid:8
    v_mfma_f32_4x4x4_16b_bf16 v[92:95], v[84:85], v[78:79], v[92:95] cbsz:4 abid:8
    s_nop 0
    v_mfma_f32_4x4x4_16b_bf16 v[88:91], v[84:85], v[80:81], v[88:91] cbsz:4 abid:12
    v_mfma_f32_4x4x4_16b_bf16 v[92:95], v[84:85], v[82:83], v[92:95] cbsz:4 abid:12
    v_fma_f32 v124, v124, s68, -v86
    v_fma_f32 v125, v125, s68, -v86
    v_fma_f32 v126, v126, s68, -v86
    v_fma_f32 v127, v127, s68, -v86
    v_exp_f32 v124, v124
    v_exp_f32 v125, v125
    v_exp_f32 v126, v126
    v_exp_f32 v127, v127
    s_nop 0
    v_add_f32 v87, v87, v124
    v_cvt_pk_bf16_f32 v84, v124, v125
    v_add_f32 v87, v87, v125
    v_add_f32 v87, v87, v126
    v_cvt_pk_bf16_f32 v85, v126, v127
    v_add_f32 v87, v87, v127
    s_waitcnt vmcnt(8)
    ds_read_b64_tr_b16 v[68:69], v22 offset:8192
    ds_read_b64_tr_b16 v[70:71], v23 offset:8192
    ds_read_b64_tr_b16 v[72:73], v22 offset:9216
    ds_read_b64_tr_b16 v[74:75], v23 offset:9216
    ds_read_b64_tr_b16 v[76:77], v22 offset:10240
    ds_read_b64_tr_b16 v[78:79], v23 offset:10240
    ds_read_b64_tr_b16 v[80:81], v22 offset:11264
    ds_read_b64_tr_b16 v[82:83], v23 offset:11264
    s_add_u32 s67, s61, 163840
    s_add_u32 m0, s62, 8192
    s_waitcnt lgkmcnt(0)
    buffer_load_dwordx4 v16, s[32:35], s67 offen nt lds
    buffer_load_dwordx4 v16, s[32:35], s67 offen offset:1024 nt lds
    buffer_load_dwordx4 v16, s[32:35], s67 offen offset:2048 nt lds
    buffer_load_dwordx4 v16, s[32:35], s67 offen offset:3072 nt lds
    v_mfma_f32_4x4x4_16b_bf16 v[88:91], v[84:85], v[68:69], v[88:91] cbsz:4 abid:0
    v_mfma_f32_4x4x4_16b_bf16 v[92:95], v[84:85], v[70:71], v[92:95] cbsz:4 abid:0
    s_nop 0
    v_mfma_f32_4x4x4_16b_bf16 v[88:91], v[84:85], v[72:73], v[88:91] cbsz:4 abid:4
    v_mfma_f32_4x4x4_16b_bf16 v[92:95], v[84:85], v[74:75], v[92:95] cbsz:4 abid:4
    s_nop 0
    v_mfma_f32_4x4x4_16b_bf16 v[88:91], v[84:85], v[76:77], v[88:91] cbsz:4 abid:8
    v_mfma_f32_4x4x4_16b_bf16 v[92:95], v[84:85], v[78:79], v[92:95] cbsz:4 abid:8
    s_nop 0
    v_mfma_f32_4x4x4_16b_bf16 v[88:91], v[84:85], v[80:81], v[88:91] cbsz:4 abid:12
    v_mfma_f32_4x4x4_16b_bf16 v[92:95], v[84:85], v[82:83], v[92:95] cbsz:4 abid:12
    v_fma_f32 v128, v128, s68, -v86
    v_fma_f32 v129, v129, s68, -v86
    v_fma_f32 v130, v130, s68, -v86
    v_fma_f32 v131, v131, s68, -v86
    v_exp_f32 v128, v128
    v_exp_f32 v129, v129
    v_exp_f32 v130, v130
    v_exp_f32 v131, v131
    s_nop 0
    v_add_f32 v87, v87, v128
    v_cvt_pk_bf16_f32 v84, v128, v129
    v_add_f32 v87, v87, v129
    v_add_f32 v87, v87, v130
    v_cvt_pk_bf16_f32 v85, v130, v131
    v_add_f32 v87, v87, v131
    s_waitcnt vmcnt(8)
    ds_read_b64_tr_b16 v[68:69], v22 offset:0
    ds_read_b64_tr_b16 v[70:71], v23 offset:0
    ds_read_b64_tr_b16 v[72:73], v22 offset:1024
    ds_read_b64_tr_b16 v[74:75], v23 offset:1024
    ds_read_b64_tr_b16 v[76:77], v22 offset:2048
    ds_read_b64_tr_b16 v[78:79], v23 offset:2048
    ds_read_b64_tr_b16 v[80:81], v22 offset:3072
    ds_read_b64_tr_b16 v[82:83], v23 offset:3072
    s_add_u32 s67, s61, 180224
    s_add_u32 m0, s62, 0
    s_waitcnt lgkmcnt(0)
    buffer_load_dwordx4 v16, s[32:35], s67 offen nt lds
    buffer_load_dwordx4 v16, s[32:35], s67 offen offset:1024 nt lds
    buffer_load_dwordx4 v16, s[32:35], s67 offen offset:2048 nt lds
    buffer_load_dwordx4 v16, s[32:35], s67 offen offset:3072 nt lds
    v_mfma_f32_4x4x4_16b_bf16 v[88:91], v[84:85], v[68:69], v[88:91] cbsz:4 abid:0
    v_mfma_f32_4x4x4_16b_bf16 v[92:95], v[84:85], v[70:71], v[92:95] cbsz:4 abid:0
    s_nop 0
    v_mfma_f32_4x4x4_16b_bf16 v[88:91], v[84:85], v[72:73], v[88:91] cbsz:4 abid:4
    v_mfma_f32_4x4x4_16b_bf16 v[92:95], v[84:85], v[74:75], v[92:95] cbsz:4 abid:4
    s_nop 0
    v_mfma_f32_4x4x4_16b_bf16 v[88:91], v[84:85], v[76:77], v[88:91] cbsz:4 abid:8
    v_mfma_f32_4x4x4_16b_bf16 v[92:95], v[84:85], v[78:79], v[92:95] cbsz:4 abid:8
    s_nop 0
    v_mfma_f32_4x4x4_16b_bf16 v[88:91], v[84:85], v[80:81], v[88:91] cbsz:4 abid:12
    v_mfma_f32_4x4x4_16b_bf16 v[92:95], v[84:85], v[82:83], v[92:95] cbsz:4 abid:12
    v_fma_f32 v132, v132, s68, -v86
    v_fma_f32 v133, v133, s68, -v86
    v_fma_f32 v134, v134, s68, -v86
    v_fma_f32 v135, v135, s68, -v86
    v_exp_f32 v132, v132
    v_exp_f32 v133, v133
    v_exp_f32 v134, v134
    v_exp_f32 v135, v135
    s_nop 0
    v_add_f32 v87, v87, v132
    v_cvt_pk_bf16_f32 v84, v132, v133
    v_add_f32 v87, v87, v133
    v_add_f32 v87, v87, v134
    v_cvt_pk_bf16_f32 v85, v134, v135
    v_add_f32 v87, v87, v135
    s_waitcnt vmcnt(8)
    ds_read_b64_tr_b16 v[68:69], v22 offset:4096
    ds_read_b64_tr_b16 v[70:71], v23 offset:4096
    ds_read_b64_tr_b16 v[72:73], v22 offset:5120
    ds_read_b64_tr_b16 v[74:75], v23 offset:5120
    ds_read_b64_tr_b16 v[76:77], v22 offset:6144
    ds_read_b64_tr_b16 v[78:79], v23 offset:6144
    ds_read_b64_tr_b16 v[80:81], v22 offset:7168
    ds_read_b64_tr_b16 v[82:83], v23 offset:7168
    s_add_u32 s67, s61, 196608
    s_add_u32 m0, s62, 4096
    s_waitcnt lgkmcnt(0)
    buffer_load_dwordx4 v16, s[32:35], s67 offen nt lds
    buffer_load_dwordx4 v16, s[32:35], s67 offen offset:1024 nt lds
    buffer_load_dwordx4 v16, s[32:35], s67 offen offset:2048 nt lds
    buffer_load_dwordx4 v16, s[32:35], s67 offen offset:3072 nt lds
    v_mfma_f32_4x4x4_16b_bf16 v[88:91], v[84:85], v[68:69], v[88:91] cbsz:4 abid:0
    v_mfma_f32_4x4x4_16b_bf16 v[92:95], v[84:85], v[70:71], v[92:95] cbsz:4 abid:0
    s_nop 0
    v_mfma_f32_4x4x4_16b_bf16 v[88:91], v[84:85], v[72:73], v[88:91] cbsz:4 abid:4
    v_mfma_f32_4x4x4_16b_bf16 v[92:95], v[84:85], v[74:75], v[92:95] cbsz:4 abid:4
    s_nop 0
    v_mfma_f32_4x4x4_16b_bf16 v[88:91], v[84:85], v[76:77], v[88:91] cbsz:4 abid:8
    v_mfma_f32_4x4x4_16b_bf16 v[92:95], v[84:85], v[78:79], v[92:95] cbsz:4 abid:8
    s_nop 0
    v_mfma_f32_4x4x4_16b_bf16 v[88:91], v[84:85], v[80:81], v[88:91] cbsz:4 abid:12
    v_mfma_f32_4x4x4_16b_bf16 v[92:95], v[84:85], v[82:83], v[92:95] cbsz:4 abid:12
    v_fma_f32 v136, v136, s68, -v86
    v_fma_f32 v137, v137, s68, -v86
    v_fma_f32 v138, v138, s68, -v86
    v_fma_f32 v139, v139, s68, -v86
    v_exp_f32 v136, v136
    v_exp_f32 v137, v137
    v_exp_f32 v138, v138
    v_exp_f32 v139, v139
    s_nop 0
    v_add_f32 v87, v87, v136
    v_cvt_pk_bf16_f32 v84, v136, v137
    v_add_f32 v87, v87, v137
    v_add_f32 v87, v87, v138
    v_cvt_pk_bf16_f32 v85, v138, v139
    v_add_f32 v87, v87, v139
    v_mov_b32 v6, 49160
    v_mov_b32 v7, 0x5eed1e59
    ds_write_b32 v6, v7
    s_waitcnt vmcnt(8)
    ds_read_b64_tr_b16 v[68:69], v22 offset:8192
    ds_read_b64_tr_b16 v[70:71], v23 offset:8192
    ds_read_b64_tr_b16 v[72:73], v22 offset:9216
    ds_read_b64_tr_b16 v[74:75], v23 offset:9216
    ds_read_b64_tr_b16 v[76:77], v22 offset:10240
    ds_read_b64_tr_b16 v[78:79], v23 offset:10240
    ds_read_b64_tr_b16 v[80:81], v22 offset:11264
    ds_read_b64_tr_b16 v[82:83], v23 offset:11264
    s_add_u32 s67, s61, 212992
    s_add_u32 m0, s62, 8192
    s_waitcnt lgkmcnt(0)
    buffer_load_dwordx4 v16, s[32:35], s67 offen nt lds
    buffer_load_dwordx4 v16, s[32:35], s67 offen offset:1024 nt lds
    buffer_load_dwordx4 v16, s[32:35], s67 offen offset:2048 nt lds
    buffer_load_dwordx4 v16, s[32:35], s67 offen offset:3072 nt lds
    v_mfma_f32_4x4x4_16b_bf16 v[88:91], v[84:85], v[68:69], v[88:91] cbsz:4 abid:0
    v_mfma_f32_4x4x4_16b_bf16 v[92:95], v[84:85], v[70:71], v[92:95] cbsz:4 abid:0
    s_nop 0
    v_mfma_f32_4x4x4_16b_bf16 v[88:91], v[84:85], v[72:73], v[88:91] cbsz:4 abid:4
    v_mfma_f32_4x4x4_16b_bf16 v[92:95], v[84:85], v[74:75], v[92:95] cbsz:4 abid:4
    s_nop 0
    v_mfma_f32_4x4x4_16b_bf16 v[88:91], v[84:85], v[76:77], v[88:91] cbsz:4 abid:8
    v_mfma_f32_4x4x4_16b_bf16 v[92:95], v[84:85], v[78:79], v[92:95] cbsz:4 abid:8
    s_nop 0
    v_mfma_f32_4x4x4_16b_bf16 v[88:91], v[84:85], v[80:81], v[88:91] cbsz:4 abid:12
    v_mfma_f32_4x4x4_16b_bf16 v[92:95], v[84:85], v[82:83], v[92:95] cbsz:4 abid:12
    v_fma_f32 v140, v140, s68, -v86
    v_fma_f32 v141, v141, s68, -v86
    v_fma_f32 v142, v142, s68, -v86
    v_fma_f32 v143, v143, s68, -v86
    v_exp_f32 v140, v140
    v_exp_f32 v141, v141
    v_exp_f32 v142, v142
    v_exp_f32 v143, v143
    s_nop 0
    v_add_f32 v87, v87, v140
    v_cvt_pk_bf16_f32 v84, v140, v141
    v_add_f32 v87, v87, v141
    v_add_f32 v87, v87, v142
    v_cvt_pk_bf16_f32 v85, v142, v143
    v_add_f32 v87, v87, v143
    s_waitcnt vmcnt(8)
    ds_read_b64_tr_b16 v[68:69], v22 offset:0
    ds_read_b64_tr_b16 v[70:71], v23 offset:0
    ds_read_b64_tr_b16 v[72:73], v22 offset:1024
    ds_read_b64_tr_b16 v[74:75], v23 offset:1024
    ds_read_b64_tr_b16 v[76:77], v22 offset:2048
    ds_read_b64_tr_b16 v[78:79], v23 offset:2048
    ds_read_b64_tr_b16 v[80:81], v22 offset:3072
    ds_read_b64_tr_b16 v[82:83], v23 offset:3072
    s_add_u32 s67, s61, 229376
    s_add_u32 m0, s62, 0
    s_waitcnt lgkmcnt(0)
    buffer_load_dwordx4 v16, s[32:35], s67 offen nt lds
    buffer_load_dwordx4 v16, s[32:35], s67 offen offset:1024 nt lds
    buffer_load_dwordx4 v16, s[32:35], s67 offen offset:2048 nt lds
    buffer_load_dwordx4 v16, s[32:35], s67 offen offset:3072 nt lds
    v_mfma_f32_4x4x4_16b_bf16 v[88:91], v[84:85], v[68:69], v[88:91] cbsz:4 abid:0
    v_mfma_f32_4x4x4_16b_bf16 v[92:95], v[84:85], v[70:71], v[92:95] cbsz:4 abid:0
    s_nop 0
    v_mfma_f32_4x4x4_16b_bf16 v[88:91], v[84:85], v[72:73], v[88:91] cbsz:4 abid:4
    v_mfma_f32_4x4x4_16b_bf16 v[92:95], v[84:85], v[74:75], v[92:95] cbsz:4 abid:4
    s_nop 0
    v_mfma_f32_4x4x4_16b_bf16 v[88:91], v[84:85], v[76:77], v[88:91] cbsz:4 abid:8
    v_mfma_f32_4x4x4_16b_bf16 v[92:95], v[84:85], v[78:79], v[92:95] cbsz:4 abid:8
    s_nop 0
    v_mfma_f32_4x4x4_16b_bf16 v[88:91], v[84:85], v[80:81], v[88:91] cbsz:4 abid:12
    v_mfma_f32_4x4x4_16b_bf16 v[92:95], v[84:85], v[82:83], v[92:95] cbsz:4 abid:12
    v_fma_f32 v144, v144, s68, -v86
    v_fma_f32 v145, v145, s68, -v86
    v_fma_f32 v146, v146, s68, -v86
    v_fma_f32 v147, v147, s68, -v86
    v_exp_f32 v144, v144
    v_exp_f32 v145, v145
    v_exp_f32 v146, v146
    v_exp_f32 v147, v147
    s_nop 0
    v_add_f32 v87, v87, v144
    v_cvt_pk_bf16_f32 v84, v144, v145
    v_add_f32 v87, v87, v145
    v_add_f32 v87, v87, v146
    v_cvt_pk_bf16_f32 v85, v146, v147
    v_add_f32 v87, v87, v147
    s_waitcnt vmcnt(8)
    ds_read_b64_tr_b16 v[68:69], v22 offset:4096
    ds_read_b64_tr_b16 v[70:71], v23 offset:4096
    ds_read_b64_tr_b16 v[72:73], v22 offset:5120
    ds_read_b64_tr_b16 v[74:75], v23 offset:5120
    ds_read_b64_tr_b16 v[76:77], v22 offset:6144
    ds_read_b64_tr_b16 v[78:79], v23 offset:6144
    ds_read_b64_tr_b16 v[80:81], v22 offset:7168
    ds_read_b64_tr_b16 v[82:83], v23 offset:7168
    s_add_u32 s67, s61, 245760
    s_add_u32 m0, s62, 4096
    s_waitcnt lgkmcnt(0)
    buffer_load_dwordx4 v16, s[32:35], s67 offen nt lds
    buffer_load_dwordx4 v16, s[32:35], s67 offen offset:1024 nt lds
    buffer_load_dwordx4 v16, s[32:35], s67 offen offset:2048 nt lds
    buffer_load_dwordx4 v16, s[32:35], s67 offen offset:3072 nt lds
    v_mfma_f32_4x4x4_16b_bf16 v[88:91], v[84:85], v[68:69], v[88:91] cbsz:4 abid:0
    v_mfma_f32_4x4x4_16b_bf16 v[92:95], v[84:85], v[70:71], v[92:95] cbsz:4 abid:0
    s_nop 0
    v_mfma_f32_4x4x4_16b_bf16 v[88:91], v[84:85], v[72:73], v[88:91] cbsz:4 abid:4
    v_mfma_f32_4x4x4_16b_bf16 v[92:95], v[84:85], v[74:75], v[92:95] cbsz:4 abid:4
    s_nop 0
    v_mfma_f32_4x4x4_16b_bf16 v[88:91], v[84:85], v[76:77], v[88:91] cbsz:4 abid:8
    v_mfma_f32_4x4x4_16b_bf16 v[92:95], v[84:85], v[78:79], v[92:95] cbsz:4 abid:8
    s_nop 0
    v_mfma_f32_4x4x4_16b_bf16 v[88:91], v[84:85], v[80:81], v[88:91] cbsz:4 abid:12
    v_mfma_f32_4x4x4_16b_bf16 v[92:95], v[84:85], v[82:83], v[92:95] cbsz:4 abid:12
    v_fma_f32 v148, v148, s68, -v86
    v_fma_f32 v149, v149, s68, -v86
    v_fma_f32 v150, v150, s68, -v86
    v_fma_f32 v151, v151, s68, -v86
    v_exp_f32 v148, v148
    v_exp_f32 v149, v149
    v_exp_f32 v150, v150
    v_exp_f32 v151, v151
    s_nop 0
    v_add_f32 v87, v87, v148
    v_cvt_pk_bf16_f32 v84, v148, v149
    v_add_f32 v87, v87, v149
    v_add_f32 v87, v87, v150
    v_cvt_pk_bf16_f32 v85, v150, v151
    v_add_f32 v87, v87, v151
    s_waitcnt vmcnt(8)
    ds_read_b64_tr_b16 v[68:69], v22 offset:8192
    ds_read_b64_tr_b16 v[70:71], v23 offset:8192
    ds_read_b64_tr_b16 v[72:73], v22 offset:9216
    ds_read_b64_tr_b16 v[74:75], v23 offset:9216
    ds_read_b64_tr_b16 v[76:77], v22 offset:10240
    ds_read_b64_tr_b16 v[78:79], v23 offset:10240
    ds_read_b64_tr_b16 v[80:81], v22 offset:11264
    ds_read_b64_tr_b16 v[82:83], v23 offset:11264
    s_waitcnt lgkmcnt(6)
    v_mfma_f32_4x4x4_16b_bf16 v[88:91], v[84:85], v[68:69], v[88:91] cbsz:4 abid:0
    v_mfma_f32_4x4x4_16b_bf16 v[92:95], v[84:85], v[70:71], v[92:95] cbsz:4 abid:0
    s_waitcnt lgkmcnt(4)
    v_mfma_f32_4x4x4_16b_bf16 v[88:91], v[84:85], v[72:73], v[88:91] cbsz:4 abid:4
    v_mfma_f32_4x4x4_16b_bf16 v[92:95], v[84:85], v[74:75], v[92:95] cbsz:4 abid:4
    s_waitcnt lgkmcnt(2)
    v_mfma_f32_4x4x4_16b_bf16 v[88:91], v[84:85], v[76:77], v[88:91] cbsz:4 abid:8
    v_mfma_f32_4x4x4_16b_bf16 v[92:95], v[84:85], v[78:79], v[92:95] cbsz:4 abid:8
    s_waitcnt lgkmcnt(0)
    v_mfma_f32_4x4x4_16b_bf16 v[88:91], v[84:85], v[80:81], v[88:91] cbsz:4 abid:12
    v_mfma_f32_4x4x4_16b_bf16 v[92:95], v[84:85], v[82:83], v[92:95] cbsz:4 abid:12
    v_fma_f32 v152, v152, s68, -v86
    v_fma_f32 v153, v153, s68, -v86
    v_fma_f32 v154, v154, s68, -v86
    v_fma_f32 v155, v155, s68, -v86
    v_exp_f32 v152, v152
    v_exp_f32 v153, v153
    v_exp_f32 v154, v154
    v_exp_f32 v155, v155
    s_nop 0
    v_add_f32 v87, v87, v152
    v_cvt_pk_bf16_f32 v84, v152, v153
    v_add_f32 v87, v87, v153
    v_add_f32 v87, v87, v154
    v_cvt_pk_bf16_f32 v85, v154, v155
    v_add_f32 v87, v87, v155
    v_fma_f32 v156, v156, s68, -v86
    v_fma_f32 v157, v157, s68, -v86
    v_fma_f32 v158, v158, s68, -v86
    v_fma_f32 v159, v159, s68, -v86
    v_exp_f32 v156, v156
    v_exp_f32 v157, v157
    v_exp_f32 v158, v158
    v_exp_f32 v159, v159
    s_nop 0
    v_add_f32 v87, v87, v156
    v_cvt_pk_bf16_f32 v24, v156, v157
    v_add_f32 v87, v87, v157
    v_add_f32 v87, v87, v158
    v_cvt_pk_bf16_f32 v25, v158, v159
    v_add_f32 v87, v87, v159
    v_mov_b32 v2, v87
    v_lshlrev_b32 v7, 3, v1
    s_lshl_b32 s64, s60, 5
    v_permlane16_swap_b32 v87, v2
    v_add_f32 v87, v87, v2
    v_mov_b32 v2, v87
    v_add_u32 v7, s64, v7
    s_lshl_b32 s64, s60, 3
    v_permlane32_swap_b32 v87, v2
    v_add_f32 v87, v87, v2
    v_mov_b32 v9, s64
    s_mov_b64 exec, 0xf
    ds_write_b64 v7, v[86:87] offset:49216
    s_mov_b64 exec, -1
    v_mov_b32 v10, 49152
    v_lshlrev_b32 v11, 2, v1
    v_add_u32 v11, 49408, v11
    s_waitcnt lgkmcnt(0)
    s_barrier
    ds_read_b64 v[52:53], v9 offset:49216
    ds_read_b64 v[54:55], v9 offset:49248
    ds_read_b64 v[56:57], v9 offset:49280
    ds_read_b64 v[58:59], v9 offset:49312
    ds_read_b64 v[30:31], v10
    ds_read_b32 v28, v9 offset:49168
    ds_read2st64_b32 v[26:27], v11 offset0:0 offset1:1
    v_lshlrev_b32 v8, 2, v1
    v_add_u32 v5, s62, v8
    s_lshl_b32 s64, s60, 9
    v_add_u32 v8, s64, v8
    v_lshlrev_b32 v11, 4, v1
    s_waitcnt lgkmcnt(0)
    v_max3_f32 v62, v52, v54, v56
    v_readfirstlane_b32 s71, v28
    v_max_f32 v62, v62, v58
    v_sub_f32 v52, v52, v62
    v_sub_f32 v54, v54, v62
    v_sub_f32 v56, v56, v62
    v_sub_f32 v58, v58, v62
    v_exp_f32 v52, v52
    v_exp_f32 v54, v54
    v_exp_f32 v56, v56
    v_exp_f32 v58, v58
    v_mov_b32 v63, v31
    v_mul_f32 v6, v52, v53
    v_fmac_f32 v6, v54, v55
    v_fmac_f32 v6, v56, v57
    v_fmac_f32 v6, v58, v59
    v_rcp_f32 v7, v6
    v_log_f32 v6, v6
    s_nop 0
    v_mul_f32 v52, v52, v7
    v_mul_f32 v54, v54, v7
    v_mul_f32 v56, v56, v7
    v_mul_f32 v58, v58, v7
    v_add_f32 v62, v62, v6
    v_max_f32 v66, v62, v30
    s_waitcnt vmcnt(4)
    ds_read_b64_tr_b16 v[68:69], v22 offset:0
    ds_read_b64_tr_b16 v[70:71], v23 offset:0
    ds_read_b64_tr_b16 v[72:73], v22 offset:1024
    ds_read_b64_tr_b16 v[74:75], v23 offset:1024
    ds_read_b64_tr_b16 v[76:77], v22 offset:2048
    ds_read_b64_tr_b16 v[78:79], v23 offset:2048
    ds_read_b64_tr_b16 v[80:81], v22 offset:3072
    ds_read_b64_tr_b16 v[82:83], v23 offset:3072
    s_waitcnt lgkmcnt(6)
    v_mfma_f32_4x4x4_16b_bf16 v[88:91], v[84:85], v[68:69], v[88:91] cbsz:4 abid:0
    v_mfma_f32_4x4x4_16b_bf16 v[92:95], v[84:85], v[70:71], v[92:95] cbsz:4 abid:0
    s_waitcnt lgkmcnt(4)
    v_mfma_f32_4x4x4_16b_bf16 v[88:91], v[84:85], v[72:73], v[88:91] cbsz:4 abid:4
    v_mfma_f32_4x4x4_16b_bf16 v[92:95], v[84:85], v[74:75], v[92:95] cbsz:4 abid:4
    s_waitcnt lgkmcnt(2)
    v_mfma_f32_4x4x4_16b_bf16 v[88:91], v[84:85], v[76:77], v[88:91] cbsz:4 abid:8
    v_mfma_f32_4x4x4_16b_bf16 v[92:95], v[84:85], v[78:79], v[92:95] cbsz:4 abid:8
    s_waitcnt lgkmcnt(0)
    v_mfma_f32_4x4x4_16b_bf16 v[88:91], v[84:85], v[80:81], v[88:91] cbsz:4 abid:12
    v_mfma_f32_4x4x4_16b_bf16 v[92:95], v[84:85], v[82:83], v[92:95] cbsz:4 abid:12
    s_waitcnt vmcnt(0)
    ds_read_b64_tr_b16 v[68:69], v22 offset:4096
    ds_read_b64_tr_b16 v[70:71], v23 offset:4096
    ds_read_b64_tr_b16 v[72:73], v22 offset:5120
    ds_read_b64_tr_b16 v[74:75], v23 offset:5120
    ds_read_b64_tr_b16 v[76:77], v22 offset:6144
    ds_read_b64_tr_b16 v[78:79], v23 offset:6144
    ds_read_b64_tr_b16 v[80:81], v22 offset:7168
    ds_read_b64_tr_b16 v[82:83], v23 offset:7168
    s_waitcnt lgkmcnt(6)
    v_mfma_f32_4x4x4_16b_bf16 v[88:91], v[24:25], v[68:69], v[88:91] cbsz:4 abid:0
    v_mfma_f32_4x4x4_16b_bf16 v[92:95], v[24:25], v[70:71], v[92:95] cbsz:4 abid:0
    s_waitcnt lgkmcnt(4)
    v_mfma_f32_4x4x4_16b_bf16 v[88:91], v[24:25], v[72:73], v[88:91] cbsz:4 abid:4
    v_mfma_f32_4x4x4_16b_bf16 v[92:95], v[24:25], v[74:75], v[92:95] cbsz:4 abid:4
    s_waitcnt lgkmcnt(2)
    v_mfma_f32_4x4x4_16b_bf16 v[88:91], v[24:25], v[76:77], v[88:91] cbsz:4 abid:8
    v_mfma_f32_4x4x4_16b_bf16 v[92:95], v[24:25], v[78:79], v[92:95] cbsz:4 abid:8
    s_waitcnt lgkmcnt(0)
    v_mfma_f32_4x4x4_16b_bf16 v[88:91], v[24:25], v[80:81], v[88:91] cbsz:4 abid:12
    v_mfma_f32_4x4x4_16b_bf16 v[92:95], v[24:25], v[82:83], v[92:95] cbsz:4 abid:12
    s_nop 4
    ds_write2st64_b32 v5, v88, v92 offset0:32 offset1:33
    ds_write2st64_b32 v5, v89, v93 offset0:34 offset1:35
    ds_write2st64_b32 v5, v90, v94 offset0:36 offset1:37
    ds_write2st64_b32 v5, v91, v95 offset0:38 offset1:39
    s_waitcnt lgkmcnt(0)
    s_barrier
    ds_read2st64_b32 v[32:33], v8 offset0:32 offset1:33
    ds_read2st64_b32 v[34:35], v8 offset0:80 offset1:81
    ds_read2st64_b32 v[36:37], v8 offset0:128 offset1:129
    ds_read2st64_b32 v[38:39], v8 offset0:176 offset1:177
    s_cmp_eq_u32 s60, s22
    s_cbranch_scc1 L_consume
    s_cmp_eq_u32 s71, s91
    s_waitcnt lgkmcnt(2)
    v_mul_f32 v60, v52, v32
    v_mul_f32 v61, v52, v33
    v_fmac_f32 v60, v54, v34
    v_fmac_f32 v61, v54, v35
    s_waitcnt lgkmcnt(0)
    v_fmac_f32 v60, v56, v36
    v_fmac_f32 v61, v56, v37
    v_fmac_f32 v60, v58, v38
    v_fmac_f32 v61, v58, v39
    s_cbranch_scc0 L_sendfar
    buffer_store_dwordx4 v[60:63], v11, s[44:47], s90 offen
    s_endpgm
L_sendfar:
    buffer_store_dwordx4 v[60:63], v11, s[44:47], s90 offen sc1
    s_endpgm
L_consume:
    buffer_load_dwordx4 v[72:75], v11, s[44:47], s90 offen sc1
    buffer_load_dwordx4 v[76:79], v11, s[44:47], s90 offen offset:1024 sc1
    buffer_load_dwordx4 v[80:83], v11, s[44:47], s90 offen offset:2048 sc1
    v_sub_f32 v30, v30, v66
    v_sub_f32 v62, v62, v66
    v_exp_f32 v30, v30
    v_exp_f32 v62, v62
    s_mov_b32 s23, 0x40000
    s_lshl_b32 s64, s69, 8
    s_waitcnt lgkmcnt(0)
    v_mul_f32 v60, v52, v32
    v_mul_f32 v61, v52, v33
    v_fmac_f32 v60, v54, v34
    v_fmac_f32 v61, v54, v35
    v_fmac_f32 v60, v56, v36
    v_fmac_f32 v61, v56, v37
    v_fmac_f32 v60, v58, v38
    v_fmac_f32 v61, v58, v39
    v_mul_f32 v64, v30, v26
    v_mul_f32 v65, v30, v27
    v_add_f32 v30, v30, v62
    v_fmac_f32 v64, v62, v60
    v_fmac_f32 v65, v62, v61
    v_lshlrev_b32 v5, 1, v1
    buffer_load_dwordx4 v[96:99], v11, s[44:47], s90 offen sc1
    buffer_load_dwordx4 v[100:103], v11, s[44:47], s90 offen offset:1024 sc1
    buffer_load_dwordx4 v[104:107], v11, s[44:47], s90 offen offset:2048 sc1
L_poll:
    s_sub_u32 s23, s23, 1
    s_cbranch_scc1 L_giveup
    s_waitcnt vmcnt(3)
    v_xor_b32 v8, v75, v31
    v_xor_b32 v9, v79, v31
    v_xor_b32 v10, v83, v31
    v_or3_b32 v8, v8, v9, v10
    v_cmp_ne_u32 vcc, 0, v8
    s_cbranch_vccz L_got0
    buffer_load_dwordx4 v[72:75], v11, s[44:47], s90 offen sc1
    buffer_load_dwordx4 v[76:79], v11, s[44:47], s90 offen offset:1024 sc1
    buffer_load_dwordx4 v[80:83], v11, s[44:47], s90 offen offset:2048 sc1
    s_waitcnt vmcnt(3)
    v_xor_b32 v8, v99, v31
    v_xor_b32 v9, v103, v31
    v_xor_b32 v10, v107, v31
    v_or3_b32 v8, v8, v9, v10
    v_cmp_ne_u32 vcc, 0, v8
    s_cbranch_vccz L_got1
    buffer_load_dwordx4 v[96:99], v11, s[44:47], s90 offen sc1
    buffer_load_dwordx4 v[100:103], v11, s[44:47], s90 offen offset:1024 sc1
    buffer_load_dwordx4 v[104:107], v11, s[44:47], s90 offen offset:2048 sc1
    s_branch L_poll
L_giveup:
    s_waitcnt vmcnt(0)
L_got0:
    v_max3_f32 v8, v74, v78, v82
    v_max_f32 v8, v8, v66
    v_sub_f32 v66, v66, v8
    v_sub_f32 v74, v74, v8
    v_sub_f32 v78, v78, v8
    v_sub_f32 v82, v82, v8
    v_exp_f32 v66, v66
    v_exp_f32 v74, v74
    v_exp_f32 v78, v78
    v_exp_f32 v82, v82
    s_nop 0
    v_fma_f32 v30, v66, v30, v74
    v_mul_f32 v64, v66, v64
    v_add_f32 v30, v30, v78
    v_mul_f32 v65, v66, v65
    v_add_f32 v30, v30, v82
    v_fmac_f32 v64, v74, v72
    v_rcp_f32 v30, v30
    v_fmac_f32 v65, v74, v73
    v_fmac_f32 v64, v78, v76
    v_fmac_f32 v65, v78, v77
    v_fmac_f32 v64, v82, v80
    v_fmac_f32 v65, v82, v81
    v_mul_f32 v64, v64, v30
    v_mul_f32 v65, v65, v30
    v_cvt_pk_bf16_f32 v64, v64, v65
    buffer_store_short v64, v5, s[40:43], s64 offen
    buffer_store_short_d16_hi v64, v5, s[40:43], s64 offen offset:128
    s_endpgm
L_got1:
    v_max3_f32 v8, v98, v102, v106
    v_max_f32 v8, v8, v66
    v_sub_f32 v66, v66, v8
    v_sub_f32 v98, v98, v8
    v_sub_f32 v102, v102, v8
    v_sub_f32 v106, v106, v8
    v_exp_f32 v66, v66
    v_exp_f32 v98, v98
    v_exp_f32 v102, v102
    v_exp_f32 v106, v106
    s_nop 0
    v_fma_f32 v30, v66, v30, v98
    v_mul_f32 v64, v66, v64
    v_add_f32 v30, v30, v102
    v_mul_f32 v65, v66, v65
    v_add_f32 v30, v30, v106
    v_fmac_f32 v64, v98, v96
    v_rcp_f32 v30, v30
    v_fmac_f32 v65, v98, v97
    v_fmac_f32 v64, v102, v100
    v_fmac_f32 v65, v102, v101
    v_fmac_f32 v64, v106, v104
    v_fmac_f32 v65, v106, v105
    v_mul_f32 v64, v64, v30
    v_mul_f32 v65, v65, v30
    v_cvt_pk_bf16_f32 v64, v64, v65
    buffer_store_short v64, v5, s[40:43], s64 offen
    buffer_store_short_d16_hi v64, v5, s[40:43], s64 offen offset:128
    s_endpgm
L_helper:
    s_load_dwordx2 s[20:21], s[0:1], 64
    v_mov_b32 v6, 49152
    v_mov_b32 v7, 0
    ds_write_b32 v6, v7 offset:8
    v_mov_b32 v8, 0x40000000
    s_lshl_b32 s65, s63, 8
    v_lshlrev_b32 v7, 4, v3
    v_cmp_eq_u32 vcc, 0, v4
    v_add_u32 v7, s65, v7
    s_lshl_b32 s64, s63, 10
    v_cndmask_b32 v7, v8, v7, vcc
    v_lshlrev_b32 v9, 8, v4
    v_cmp_gt_u32 vcc, 4, v4
    v_lshl_add_u32 v9, v3, 4, v9
    v_add_u32 v9, s64, v9
    v_cndmask_b32 v9, v8, v9, vcc
    s_lshr_b32 s66, s63, 3
    s_lshl_b32 s66, s66, 1
    v_mov_b32 v10, s66
    v_lshlrev_b32 v11, 1, v1
    v_mov_b32 v6, 0
    s_getreg_b32 s91, hwreg(HW_REG_XCC_ID, 0, 4)
    s_mov_b32 s68, 0x3e0293ee
    s_waitcnt lgkmcnt(0)
    s_mov_b32 s48, s10
    s_and_b32 s49, s11, 0xffff
    s_mov_b32 s50, 0x4000
    s_mov_b32 s51, 0x20000
    s_mov_b32 s24, s4
    s_and_b32 s25, s5, 0xffff
    s_mov_b32 s26, 0x10000
    s_mov_b32 s27, 0x20000
    s_mov_b32 s52, s14
    s_and_b32 s53, s15, 0xffff
    s_mov_b32 s54, 0x10
    s_mov_b32 s55, 0x20000
    s_mov_b32 s36, s12
    s_and_b32 s37, s13, 0xffff
    s_mov_b32 s38, 0x4000
    s_mov_b32 s39, 0x20000
    s_mov_b32 s44, s20
    s_and_b32 s45, s21, 0xffff
    s_mov_b32 s46, 0x108000
    s_mov_b32 s47, 0x20000
    s_mov_b32 s56, s18
    s_and_b32 s57, s19, 0xffff
    s_mov_b32 s58, 0x100
    s_mov_b32 s59, 0x20000
    s_cmp_eq_u32 s69, 0
    s_cselect_b32 s64, 0, 0x40000000
    v_mov_b32 v52, s64
    buffer_load_dword v50, v52, s[44:47], 0 offen offset:12 sc1
    buffer_load_dwordx4 v[12:15], v7, s[48:51], 0 offen
    buffer_load_dwordx4 v[28:31], v9, s[24:27], 0 offen
    buffer_load_dwordx4 v[16:19], v7, s[48:51], 0 offen offset:64
    buffer_load_dwordx4 v[32:35], v9, s[24:27], 0 offen offset:64
    buffer_load_dwordx4 v[20:23], v7, s[48:51], 0 offen offset:128
    buffer_load_dwordx4 v[36:39], v9, s[24:27], 0 offen offset:128
    buffer_load_dwordx4 v[24:27], v7, s[48:51], 0 offen offset:192
    buffer_load_dwordx4 v[40:43], v9, s[24:27], 0 offen offset:192
    buffer_load_ushort v48, v11, s[36:39], s65 offen
    buffer_load_ushort v53, v11, s[36:39], s65 offen offset:128
    buffer_load_ushort v49, v10, s[52:55], 0 offen
    s_waitcnt vmcnt(0)
    v_add_u32 v50, 1, v50
    v_mov_b32 v51, 1
    s_mov_b64 exec, 1
    buffer_store_dwordx2 v[50:51], v52, s[56:59], 0 offen sc1
    s_mov_b64 exec, -1
    v_mfma_f32_16x16x32_bf16 v[44:47], v[12:15], v[28:31], 0
    v_mfma_f32_16x16x32_bf16 v[44:47], v[16:19], v[32:35], v[44:47]
    v_mfma_f32_16x16x32_bf16 v[44:47], v[20:23], v[36:39], v[44:47]
    v_mfma_f32_16x16x32_bf16 v[44:47], v[24:27], v[40:43], v[44:47]
    v_lshlrev_b32 v11, 2, v1
    v_lshlrev_b32 v48, 16, v48
    v_lshlrev_b32 v53, 16, v53
    v_add_u32 v11, 49408, v11
    ds_write2st64_b32 v11, v48, v53 offset0:0 offset1:1
    v_lshlrev_b32 v49, 16, v49
    v_sub_f32 v49, 1.0, v49
    v_mul_f32 v49, 0xceabfb8f, v49
    v_mov_b32 v9, 49152
    s_nop 2
    v_readlane_b32 s66, v44, s22
    s_nop 1
    v_mov_b32 v12, s66
    v_fma_f32 v12, v12, s68, v49
    s_mov_b32 s23, 0x4000
L_prog1:
    ds_read_b32 v14, v9 offset:8
    s_sub_u32 s23, s23, 1
    s_cbranch_scc1 L_prog1_ok
    s_waitcnt lgkmcnt(0)
    v_readfirstlane_b32 s66, v14
    s_sub_u32 s66, s66, 0x5eed1e57
    s_cmp_le_u32 s66, 2
    s_cbranch_scc1 L_prog1_ok
    s_sleep 4
    s_branch L_prog1
L_prog1_ok:
    s_waitcnt lgkmcnt(0)
    s_mov_b32 s23, 0x40000
L_tagloop:
    buffer_load_dwordx2 v[28:29], v6, s[56:59], 0 offen sc1
    s_sub_u32 s23, s23, 1
    s_cbranch_scc1 L_tagok
    s_waitcnt vmcnt(0)
    v_readfirstlane_b32 s66, v29
    s_cmp_eq_u32 s66, 1
    s_cbranch_scc1 L_tagok
    s_sleep 16
    s_branch L_tagloop
L_tagok:
    s_waitcnt vmcnt(0)
    v_mov_b32 v13, v28
    v_mov_b32 v30, s91
    v_mov_b32 v31, v28
    s_lshl_b32 s64, s69, 7
    s_add_u32 s64, s64, 0x100000
    s_mov_b64 exec, 1
    buffer_store_dwordx2 v[30:31], v6, s[44:47], s64 offen sc1
    s_mov_b64 exec, -1
    s_mov_b32 s23, 0x4000
L_prog2:
    ds_read_b32 v14, v9 offset:8
    s_sub_u32 s23, s23, 1
    s_cbranch_scc1 L_prog2_ok
    s_waitcnt lgkmcnt(0)
    v_readfirstlane_b32 s66, v14
    s_sub_u32 s66, s66, 0x5eed1e58
    s_cmp_le_u32 s66, 1
    s_cbranch_scc1 L_prog2_ok
    s_sleep 4
    s_branch L_prog2
L_prog2_ok:
    s_waitcnt lgkmcnt(0)
    s_lshl_b32 s64, s63, 9
    s_add_u32 s64, s64, 0x100000
    v_lshlrev_b32 v32, 7, v1
    s_mov_b32 s23, 0x40000
    s_mov_b64 exec, 0xf
L_dieloop:
    buffer_load_dwordx2 v[34:35], v32, s[44:47], s64 offen sc1
    s_sub_u32 s23, s23, 1
    s_cbranch_scc1 L_dieok
    s_waitcnt vmcnt(0)
    v_cmp_ne_u32 vcc, v35, v13
    s_cbranch_vccz L_dieok
    s_sleep 16
    s_branch L_dieloop
L_dieok:
    s_waitcnt vmcnt(0)
    v_lshlrev_b32 v33, 3, v1
    v_add_u32 v33, 49168, v33
    ds_write_b32 v33, v34
    s_mov_b64 exec, 1
    ds_write_b64 v9, v[12:13]
    s_mov_b64 exec, -1
    s_mov_b32 s23, 0x4000
L_prog3:
    ds_read_b32 v14, v9 offset:8
    s_sub_u32 s23, s23, 1
    s_cbranch_scc1 L_prog3_ok
    s_waitcnt lgkmcnt(0)
    v_readfirstlane_b32 s66, v14
    s_sub_u32 s66, s66, 0x5eed1e59
    s_cmp_le_u32 s66, 0
    s_cbranch_scc1 L_prog3_ok
    s_sleep 4
    s_branch L_prog3
L_prog3_ok:
    s_waitcnt lgkmcnt(0)
    s_lshl_b32 s90, s69, 12
    v_lshlrev_b32 v6, 4, v1
    buffer_load_dwordx4 v[28:31], v6, s[44:47], s90 offen sc1
    buffer_load_dwordx4 v[32:35], v6, s[44:47], s90 offen offset:1024 sc1
    buffer_load_dwordx4 v[36:39], v6, s[44:47], s90 offen offset:2048 sc1
    s_waitcnt vmcnt(0)
    s_waitcnt lgkmcnt(0)
L_end:
    s_endpgm
.section .rodata,"a"
.p2align 6
.amdhsa_kernel standalone__tree_speculative_verify_tree_attention_over_candidate_token_tree__decode_kernel
      .amdhsa_next_free_vgpr 160
      .amdhsa_next_free_sgpr 96
      .amdhsa_accum_offset 160
      .amdhsa_group_segment_fixed_size 0
      .amdhsa_kernarg_size 72
      .amdhsa_user_sgpr_count 2
      .amdhsa_user_sgpr_kernarg_segment_ptr 1
      .amdhsa_system_sgpr_workgroup_id_x 1
      .amdhsa_float_denorm_mode_32 3
.end_amdhsa_kernel
```
